```python
import torch

def _softmax(x, axis=-1):
    return torch.softmax(x, dim=axis)
def _gelu(x):
    return torch.nn.functional.gelu(x, approximate="tanh")
def _silu(x):
    return torch.nn.functional.silu(x)
def _sigmoid(x):
    return torch.sigmoid(x)
def _layernorm(x, axis=-1, eps=1e-5):
    m = x.mean(dim=axis, keepdim=True)
    v = x.var(dim=axis, keepdim=True, unbiased=False)
    return (x - m) / torch.sqrt(v + eps)
def _scatter_add(tgt, idx, src, axis=0):
    return tgt.clone().index_add_(axis, idx, src)
def _segment_sum(src, seg, n):
    out = torch.zeros((n,) + src.shape[1:], dtype=src.dtype)
    return out.index_add_(0, seg, src)
def _pad(x, pw):
    flat = tuple(v for pair in reversed(pw) for v in pair)
    return torch.nn.functional.pad(x, flat)

kernel_name = 'standalone__sparse_matmul_formats_ell__sparse_mat'

def setup_inputs():

    _w = (lambda a: (lambda t: t.to(torch.bfloat16) if t.is_floating_point() else t)(torch.as_tensor(a)))
    M = N = 16384
    D = 256
    K = max(1, int(0.01 * N))
    col_idx = (lambda lo, hi, *s: torch.randint(lo, hi, s))(0, N, M, K)
    vals = (lambda *s: torch.randn(*s, dtype=torch.bfloat16) * 0.05)(M, K)
    lengths = (lambda lo, hi, *s: torch.randint(lo, hi, s))(1, K + 1, M)
    mask = (torch.arange(K)[None, :] < lengths[:, None]).to(vals.dtype)
    vals = vals * mask
    b = (lambda *s: torch.randn(*s, dtype=torch.bfloat16) * 0.05)(N, D)
    return {
        "vals": _w(vals),
        "col_idx": _w(col_idx),
        "b": _w(b),
    }

def reference(vals, col_idx, b):
    gathered = b[col_idx]
    return torch.einsum("mk,mkd->md", vals, gathered)
```

```asm
; @launch grid=(2192,1,1) block=(512,1,1) lds=31840
.amdgcn_target "amdgcn-amd-amdhsa--gfx950"
.text
.globl standalone__sparse_matmul_formats_ell__sparse_mat_kernel
.p2align 8
.type standalone__sparse_matmul_formats_ell__sparse_mat_kernel,@function
standalone__sparse_matmul_formats_ell__sparse_mat_kernel:

    s_cmp_ge_u32 s2, 2192
    s_cbranch_scc1 L_end
    s_load_dwordx4 s[32:35], s[0:1], 0
    s_load_dwordx4 s[36:39], s[0:1], 16
    v_lshrrev_b32 v16, 6, v0
    v_and_b32 v0, 63, v0
    s_and_b32 s40, s2, 1
    s_bfe_u32 s24, s2, 0x20001
    s_lshr_b32 s22, s2, 3
    v_readfirstlane_b32 s20, v16
    s_and_b32 s41, s2, 3
    s_lshl_b32 s41, s41, 2
    s_lshr_b32 s21, 8995, s41
    s_lshr_b32 s49, 272, s41
    s_and_b32 s21, s21, 3
    s_and_b32 s49, s49, 3
    s_lshl_b32 s21, s21, 7
    s_lshl_b32 s49, s49, 7
    s_lshr_b32 s42, s22, 5
    s_lshl_b32 s42, s42, 2
    s_lshr_b32 s47, 30583, s42
    s_and_b32 s47, s47, 15
    s_mov_b32 s41, s22
    s_cmp_lt_u32 s22, 128
    s_cbranch_scc1 L_x0
    s_mov_b32 s47, 1
    s_mov_b32 s21, s49
    s_sub_u32 s41, s22, 128
    s_cmp_eq_u32 s40, 1
    s_cbranch_scc1 L_x1
    s_cmp_ge_u32 s22, 238
    s_cbranch_scc1 L_end
    s_branch L_x2
L_x1:
    s_cmp_lt_u32 s22, 256
    s_cbranch_scc1 L_x2
    s_sub_u32 s41, s41, 18
    s_xor_b32 s24, s24, 1
L_x2:
    s_lshr_b32 s42, s41, 5
    s_lshl_b32 s42, s42, 2
    s_lshr_b32 s42, 65244, s42
    s_and_b32 s42, s42, 15
    s_lshl_b32 s42, s42, 5
    s_and_b32 s41, s41, 31
    s_add_u32 s41, s41, s42
L_x0:
    s_lshl_b32 s41, s41, 2
    s_add_u32 s46, s41, s24
    s_mov_b32 s6, 5341184
    s_mov_b32 s7, 0x20000
    s_mov_b32 s10, 10682368
    s_mov_b32 s11, 0x20000
    s_mov_b32 s14, 8388608
    s_mov_b32 s15, 0x20000
    s_mov_b32 s18, 8388608
    s_mov_b32 s19, 0x20000
    v_lshlrev_b32 v14, 4, v0
    v_lshlrev_b32 v15, 5, v0
    v_cmp_gt_u32 vcc, 35, v0
    v_mov_b32 v13, 0x80000000
    s_mul_i32 s23, s46, 2608
    s_mul_i32 s24, s46, 5216
    v_cndmask_b32 v12, v13, v14, vcc
    v_cndmask_b32 v11, v13, v15, vcc
    v_add_u32 v11, 4096, v11
    s_waitcnt lgkmcnt(0)
    s_mov_b32 s4, s32
    s_mov_b32 s5, s33
    s_mov_b32 s8, s34
    s_mov_b32 s9, s35
    s_mov_b32 s12, s36
    s_mov_b32 s13, s37
    s_mov_b32 s16, s38
    s_mov_b32 s17, s39
    s_mov_b32 s38, s47
    s_mov_b32 s22, s46

    s_cmp_ge_u32 s20, 3
    s_cbranch_scc1 L_nold0
    s_cmp_eq_u32 s20, 2
    s_cselect_b32 s40, 35, 64
    v_cmp_gt_u32 vcc, s40, v0
    s_lshl_b32 s41, s20, 10
    s_lshl_b32 s44, s20, 11
    s_add_u32 s41, s41, s23
    s_add_u32 s42, s44, s24
    v_cndmask_b32 v9, v13, v14, vcc
    v_cndmask_b32 v10, v13, v15, vcc
    buffer_load_dwordx4 v[28:31], v9, s[4:7], s41 offen
    buffer_load_dwordx4 v[40:43], v10, s[8:11], s42 offen
    buffer_load_dwordx4 v[44:47], v10, s[8:11], s42 offen offset:16
    s_cmp_lg_u32 s20, 0
    s_cbranch_scc1 L_init
    s_cmp_eq_u32 s38, 1
    s_cbranch_scc1 L_init
    s_add_u32 s23, s23, 1335296
    s_add_u32 s24, s24, 2670592
    buffer_load_dwordx4 v[16:19], v14, s[4:7], s23 offen
    buffer_load_dwordx4 v[20:23], v14, s[4:7], s23 offen offset:1024
    buffer_load_dwordx4 v[24:27], v12, s[4:7], s23 offen offset:2048
    s_branch L_init
L_nold0:
    s_cmp_lg_u32 s20, 3
    s_cbranch_scc1 L_noctl
    s_cmp_eq_u32 s38, 1
    s_cselect_b32 s40, 8, 7
    v_lshlrev_b32 v9, 2, v0
    v_add_u32 v9, 31744, v9
    v_cmp_eq_u32 vcc, 1, v0
    v_mov_b32 v8, s40
    s_nop 0
    v_cndmask_b32 v10, 0, 1, vcc
    v_cmp_eq_u32 vcc, 0, v0
    s_nop 1
    v_cndmask_b32 v10, v10, v8, vcc
    s_mov_b64 exec, 0xffffff
    ds_write_b32 v9, v10
    s_mov_b64 exec, -1
L_noctl:
L_init:
    s_mov_b32 s29, 512
    s_mov_b32 s30, -1
    s_mov_b32 s31, 7
    s_mov_b32 s34, 0x00ffffff
    s_mov_b32 s35, 0
    s_mov_b32 s36, 0x00ff00ff
    s_mov_b32 s37, 0x00ff00ff
    s_mov_b32 s39, 0
    v_and_b32 v10, 7, v0
    v_lshlrev_b32 v1, 4, v10
    s_mov_b32 s48, 0
    v_lshrrev_b32 v2, 3, v0
    v_lshlrev_b32 v2, 2, v2
    v_lshlrev_b32 v7, 2, v0
    v_and_b32 v9, 1, v10
    v_mov_b32 v8, 0x0c0c0100
    v_mov_b32 v13, 0x01000c0c
    v_cmp_eq_u32 vcc, 1, v9
    v_bfe_u32 v9, v10, 1, 1
    s_nop 0
    v_cndmask_b32 v8, v8, v13, vcc
    v_mov_b32 v13, 0x0c0c0c0c
    v_cmp_eq_u32 vcc, 0, v9
    s_nop 1
    v_cndmask_b32 v3, v13, v8, vcc
    v_cmp_eq_u32 vcc, 1, v9
    s_nop 1
    v_cndmask_b32 v6, v13, v8, vcc
    v_lshlrev_b32 v8, 4, v10
    v_bfe_u32 v10, v0, 4, 1
    v_lshl_add_u32 v8, v10, 2, v8
    v_lshrrev_b32 v10, 5, v0
    v_lshl_add_u32 v8, v10, 3, v8
    v_add_u32 v8, 0, v8

    s_cmp_ge_u32 s20, 3
    s_cbranch_scc1 L_bar
    s_mov_b32 s26, 0x05040100
    s_mov_b32 s27, 0x07060302
    s_mov_b32 s28, 0x80008000
    s_mov_b32 s40, 0x7fff7fff
    s_mov_b32 s41, 0x00010001
    v_add_u32 v13, s44, v15
    s_cmp_lg_u32 s20, 0
    s_cbranch_scc1 L_p0a
    s_cmp_eq_u32 s38, 1
    s_cbranch_scc1 L_p0a
    s_waitcnt vmcnt(3)
    s_branch L_p0b
L_p0a:
    s_waitcnt vmcnt(0)
L_p0b:
    v_and_b32 v9, s40, v28
    v_perm_b32 v40, v41, v40, s26
    v_pk_sub_u16 v9, v9, s41
    v_and_or_b32 v40, v9, s28, v40
    v_perm_b32 v41, v40, v28, s27
    v_perm_b32 v40, v40, v28, s26
    v_and_b32 v10, s40, v29
    v_perm_b32 v42, v43, v42, s26
    v_pk_sub_u16 v10, v10, s41
    v_and_or_b32 v42, v10, s28, v42
    v_perm_b32 v43, v42, v29, s27
    v_perm_b32 v42, v42, v29, s26
    v_and_b32 v9, s40, v30
    v_perm_b32 v44, v45, v44, s26
    v_pk_sub_u16 v9, v9, s41
    v_and_or_b32 v44, v9, s28, v44
    v_perm_b32 v45, v44, v30, s27
    v_perm_b32 v44, v44, v30, s26
    v_and_b32 v10, s40, v31
    v_perm_b32 v46, v47, v46, s26
    v_pk_sub_u16 v10, v10, s41
    v_and_or_b32 v46, v10, s28, v46
    v_perm_b32 v47, v46, v31, s27
    v_perm_b32 v46, v46, v31, s26
    ds_write_b128 v13, v[40:43] offset:7168
    ds_write_b128 v13, v[44:47] offset:7184
L_bar:
    s_mov_b32 s39, 1
    s_waitcnt lgkmcnt(0)
    s_barrier
    s_cmp_eq_u32 s38, 1
    s_cbranch_scc1 L_row
    s_cmp_eq_u32 s20, 0
    s_cbranch_scc1 L_loader
    s_sub_u32 s20, s20, 1
L_row:
    s_lshr_b32 s47, s20, 3
    s_cmp_ge_u32 s47, s38
    s_cbranch_scc1 L_fin
    s_and_b32 s20, s20, 7
    s_and_b32 s33, s47, 3
    s_mul_i32 s46, s33, 6144
    s_add_u32 s46, s46, 7168
    s_cmp_lt_u32 s47, 4
    s_cselect_b32 s24, s21, s49
    s_sub_u32 s25, s24, s48
    s_mov_b32 s48, s24
    v_add_u32 v1, s25, v1
    s_cmp_eq_u32 s38, 1
    s_cselect_b32 s25, 8, s47
    s_setprio 3
    s_cmp_lt_u32 s25, 2
    s_cbranch_scc1 L_prd
    s_setprio 2
    s_cmp_lt_u32 s25, 3
    s_cbranch_scc1 L_prd
    s_setprio 1
    s_cmp_lt_u32 s25, 4
    s_cbranch_scc1 L_prd
    s_setprio 0
L_prd:
    s_cmp_lt_u32 s33, s39
    s_cbranch_scc1 L_rdy
    v_mov_b32 v14, 31748
L_spin:
    ds_read_b32 v15, v14
    s_waitcnt lgkmcnt(0)
    v_readfirstlane_b32 s39, v15
    s_cmp_lt_u32 s33, s39
    s_cbranch_scc1 L_rdy
    s_sleep 1
    s_branch L_spin
L_rdy:
    s_mul_i32 s24, s20, 652
    s_add_u32 s24, s24, s46
    v_add_u32 v10, s24, v7
    v_add_u32 v9, s24, v2
    ds_read2st64_b32 v[12:13], v10 offset0:1 offset1:2
    ds_read_b32 v11, v10
    v_mov_b32 v14, 31744
    v_mov_b32 v15, 1
    s_mov_b64 exec, 1
    ds_add_rtn_u32 v14, v14, v15
    s_mov_b64 exec, -1
    v_mov_b32 v16, 0
    v_mov_b32 v17, 0
    v_mov_b32 v18, 0
    v_mov_b32 v19, 0
    v_mov_b32 v20, 0
    v_mov_b32 v21, 0
    v_mov_b32 v22, 0
    v_mov_b32 v23, 0
    s_waitcnt lgkmcnt(0)
    v_cmp_le_i32 s[40:41], 0, v11
    v_cmp_le_i32 s[42:43], 0, v12
    v_cmp_le_i32 s[44:45], 0, v13
    v_readfirstlane_b32 s25, v14
    s_and_b64 s[44:45], s[44:45], s[30:31]
    s_flbit_i32_b64 s40, s[40:41]
    s_sub_u32 s40, 71, s40
    s_lshr_b32 s40, s40, 3
    s_flbit_i32_b64 s42, s[42:43]
    s_sub_u32 s42, 135, s42
    s_lshr_b32 s42, s42, 3
    s_flbit_i32_b64 s44, s[44:45]
    s_sub_u32 s44, 199, s44
    s_lshr_b32 s44, s44, 3
    s_cmp_eq_u32 s40, 9
    s_cselect_b32 s40, 0, s40
    s_cmp_eq_u32 s42, 17
    s_cselect_b32 s40, s40, s42
    s_cmp_eq_u32 s44, 25
    s_cselect_b32 s40, s40, s44
    s_cmp_eq_u32 s40, 0
    s_cbranch_scc1 L_epi
    s_lshl_b32 s41, s40, 5
    s_sub_u32 s41, s41, 672
    v_add_u32 v9, s41, v9
    ds_read2_b32 v[24:25], v9 offset0:160 offset1:152
    ds_read2_b32 v[26:27], v9 offset0:144 offset1:136
    ds_read2_b32 v[28:29], v9 offset0:128 offset1:120
    ds_read2_b32 v[30:31], v9 offset0:112 offset1:104
    s_cmp_eq_u32 s40, 21
    s_cselect_b64 s[42:43], s[34:35], -1
    s_waitcnt lgkmcnt(3)
    v_cndmask_b32 v24, -1.0, v24, s[42:43]
    v_mad_u32_u16 v32, v24, s29, v1 op_sel:[1,0,0,0]
    buffer_load_dwordx4 v[32:35], v32, s[12:15], 0 offen
    s_cmp_eq_u32 s40, 1
    s_cbranch_scc1 L_d1_7
    v_mad_u32_u16 v36, v25, s29, v1 op_sel:[1,0,0,0]
    buffer_load_dwordx4 v[36:39], v36, s[12:15], 0 offen
    s_cmp_eq_u32 s40, 2
    s_cbranch_scc1 L_d2_6
    s_waitcnt lgkmcnt(2)
    v_mad_u32_u16 v40, v26, s29, v1 op_sel:[1,0,0,0]
    buffer_load_dwordx4 v[40:43], v40, s[12:15], 0 offen
    s_cmp_eq_u32 s40, 3
    s_cbranch_scc1 L_d3_5
    v_mad_u32_u16 v44, v27, s29, v1 op_sel:[1,0,0,0]
    buffer_load_dwordx4 v[44:47], v44, s[12:15], 0 offen
    s_cmp_eq_u32 s40, 4
    s_cbranch_scc1 L_d4_4
    s_waitcnt lgkmcnt(1)
    v_mad_u32_u16 v48, v28, s29, v1 op_sel:[1,0,0,0]
    buffer_load_dwordx4 v[48:51], v48, s[12:15], 0 offen
    s_cmp_eq_u32 s40, 5
    s_cbranch_scc1 L_d5_3
    v_mad_u32_u16 v52, v29, s29, v1 op_sel:[1,0,0,0]
    buffer_load_dwordx4 v[52:55], v52, s[12:15], 0 offen
    s_cmp_eq_u32 s40, 6
    s_cbranch_scc1 L_d6_2
    s_waitcnt lgkmcnt(0)
    v_mad_u32_u16 v56, v30, s29, v1 op_sel:[1,0,0,0]
    buffer_load_dwordx4 v[56:59], v56, s[12:15], 0 offen
    s_cmp_eq_u32 s40, 7
    s_cbranch_scc1 L_d7_1
    v_mad_u32_u16 v60, v31, s29, v1 op_sel:[1,0,0,0]
    buffer_load_dwordx4 v[60:63], v60, s[12:15], 0 offen
    s_cmp_eq_u32 s40, 8
    s_cbranch_scc1 L_d0_0
    v_perm_b32 v4, v24, v24, v3
    v_perm_b32 v5, v24, v24, v6
    ds_read_b32 v24, v9 offset:384
    s_waitcnt vmcnt(7)
    v_mfma_f32_4x4x4_16b_bf16 v[16:19], v[4:5], v[32:33], v[16:19]
    v_mfma_f32_4x4x4_16b_bf16 v[20:23], v[4:5], v[34:35], v[20:23]
    s_cmp_eq_u32 s40, 9
    s_waitcnt lgkmcnt(0)
    v_mad_u32_u16 v32, v24, s29, v1 op_sel:[1,0,0,0]
    buffer_load_dwordx4 v[32:35], v32, s[12:15], 0 offen
    s_cbranch_scc1 L_d1_0
    v_perm_b32 v4, v25, v25, v3
    v_perm_b32 v5, v25, v25, v6
    ds_read_b32 v25, v9 offset:352
    s_waitcnt vmcnt(7)
    v_mfma_f32_4x4x4_16b_bf16 v[16:19], v[4:5], v[36:37], v[16:19]
    v_mfma_f32_4x4x4_16b_bf16 v[20:23], v[4:5], v[38:39], v[20:23]
    s_cmp_eq_u32 s40, 10
    s_waitcnt lgkmcnt(0)
    v_mad_u32_u16 v36, v25, s29, v1 op_sel:[1,0,0,0]
    buffer_load_dwordx4 v[36:39], v36, s[12:15], 0 offen
    s_cbranch_scc1 L_d2_0
    v_perm_b32 v4, v26, v26, v3
    v_perm_b32 v5, v26, v26, v6
    ds_read_b32 v26, v9 offset:320
    s_waitcnt vmcnt(7)
    v_mfma_f32_4x4x4_16b_bf16 v[16:19], v[4:5], v[40:41], v[16:19]
    v_mfma_f32_4x4x4_16b_bf16 v[20:23], v[4:5], v[42:43], v[20:23]
    s_cmp_eq_u32 s40, 11
    s_waitcnt lgkmcnt(0)
    v_mad_u32_u16 v40, v26, s29, v1 op_sel:[1,0,0,0]
    buffer_load_dwordx4 v[40:43], v40, s[12:15], 0 offen
    s_cbranch_scc1 L_d3_0
    v_perm_b32 v4, v27, v27, v3
    v_perm_b32 v5, v27, v27, v6
    ds_read_b32 v27, v9 offset:288
    s_waitcnt vmcnt(7)
    v_mfma_f32_4x4x4_16b_bf16 v[16:19], v[4:5], v[44:45], v[16:19]
    v_mfma_f32_4x4x4_16b_bf16 v[20:23], v[4:5], v[46:47], v[20:23]
    s_cmp_eq_u32 s40, 12
    s_waitcnt lgkmcnt(0)
    v_mad_u32_u16 v44, v27, s29, v1 op_sel:[1,0,0,0]
    buffer_load_dwordx4 v[44:47], v44, s[12:15], 0 offen
    s_cbranch_scc1 L_d4_0
    v_perm_b32 v4, v28, v28, v3
    v_perm_b32 v5, v28, v28, v6
    ds_read_b32 v28, v9 offset:256
    s_waitcnt vmcnt(7)
    v_mfma_f32_4x4x4_16b_bf16 v[16:19], v[4:5], v[48:49], v[16:19]
    v_mfma_f32_4x4x4_16b_bf16 v[20:23], v[4:5], v[50:51], v[20:23]
    s_cmp_eq_u32 s40, 13
    s_waitcnt lgkmcnt(0)
    v_mad_u32_u16 v48, v28, s29, v1 op_sel:[1,0,0,0]
    buffer_load_dwordx4 v[48:51], v48, s[12:15], 0 offen
    s_cbranch_scc1 L_d5_0
    v_perm_b32 v4, v29, v29, v3
    v_perm_b32 v5, v29, v29, v6
    ds_read_b32 v29, v9 offset:224
    s_waitcnt vmcnt(7)
    v_mfma_f32_4x4x4_16b_bf16 v[16:19], v[4:5], v[52:53], v[16:19]
    v_mfma_f32_4x4x4_16b_bf16 v[20:23], v[4:5], v[54:55], v[20:23]
    s_cmp_eq_u32 s40, 14
    s_waitcnt lgkmcnt(0)
    v_mad_u32_u16 v52, v29, s29, v1 op_sel:[1,0,0,0]
    buffer_load_dwordx4 v[52:55], v52, s[12:15], 0 offen
    s_cbranch_scc1 L_d6_0
    v_perm_b32 v4, v30, v30, v3
    v_perm_b32 v5, v30, v30, v6
    ds_read_b32 v30, v9 offset:192
    s_waitcnt vmcnt(7)
    v_mfma_f32_4x4x4_16b_bf16 v[16:19], v[4:5], v[56:57], v[16:19]
    v_mfma_f32_4x4x4_16b_bf16 v[20:23], v[4:5], v[58:59], v[20:23]
    s_cmp_eq_u32 s40, 15
    s_waitcnt lgkmcnt(0)
    v_mad_u32_u16 v56, v30, s29, v1 op_sel:[1,0,0,0]
    buffer_load_dwordx4 v[56:59], v56, s[12:15], 0 offen
    s_cbranch_scc1 L_d7_0
    v_perm_b32 v4, v31, v31, v3
    v_perm_b32 v5, v31, v31, v6
    ds_read_b32 v31, v9 offset:160
    s_waitcnt vmcnt(7)
    v_mfma_f32_4x4x4_16b_bf16 v[16:19], v[4:5], v[60:61], v[16:19]
    v_mfma_f32_4x4x4_16b_bf16 v[20:23], v[4:5], v[62:63], v[20:23]
    s_cmp_eq_u32 s40, 16
    s_waitcnt lgkmcnt(0)
    v_mad_u32_u16 v60, v31, s29, v1 op_sel:[1,0,0,0]
    buffer_load_dwordx4 v[60:63], v60, s[12:15], 0 offen
    s_cbranch_scc1 L_d0_0
    v_perm_b32 v4, v24, v24, v3
    v_perm_b32 v5, v24, v24, v6
    ds_read_b32 v24, v9 offset:128
    s_waitcnt vmcnt(7)
    v_mfma_f32_4x4x4_16b_bf16 v[16:19], v[4:5], v[32:33], v[16:19]
    v_mfma_f32_4x4x4_16b_bf16 v[20:23], v[4:5], v[34:35], v[20:23]
    s_cmp_eq_u32 s40, 17
    s_waitcnt lgkmcnt(0)
    v_mad_u32_u16 v32, v24, s29, v1 op_sel:[1,0,0,0]
    buffer_load_dwordx4 v[32:35], v32, s[12:15], 0 offen
    s_cbranch_scc1 L_d1_0
    v_perm_b32 v4, v25, v25, v3
    v_perm_b32 v5, v25, v25, v6
    ds_read_b32 v25, v9 offset:96
    s_waitcnt vmcnt(7)
    v_mfma_f32_4x4x4_16b_bf16 v[16:19], v[4:5], v[36:37], v[16:19]
    v_mfma_f32_4x4x4_16b_bf16 v[20:23], v[4:5], v[38:39], v[20:23]
    s_cmp_eq_u32 s40, 18
    s_waitcnt lgkmcnt(0)
    v_mad_u32_u16 v36, v25, s29, v1 op_sel:[1,0,0,0]
    buffer_load_dwordx4 v[36:39], v36, s[12:15], 0 offen
    s_cbranch_scc1 L_d2_0
    v_perm_b32 v4, v26, v26, v3
    v_perm_b32 v5, v26, v26, v6
    ds_read_b32 v26, v9 offset:64
    s_waitcnt vmcnt(7)
    v_mfma_f32_4x4x4_16b_bf16 v[16:19], v[4:5], v[40:41], v[16:19]
    v_mfma_f32_4x4x4_16b_bf16 v[20:23], v[4:5], v[42:43], v[20:23]
    s_cmp_eq_u32 s40, 19
    s_waitcnt lgkmcnt(0)
    v_mad_u32_u16 v40, v26, s29, v1 op_sel:[1,0,0,0]
    buffer_load_dwordx4 v[40:43], v40, s[12:15], 0 offen
    s_cbranch_scc1 L_d3_0
    v_perm_b32 v4, v27, v27, v3
    v_perm_b32 v5, v27, v27, v6
    ds_read_b32 v27, v9 offset:32
    s_waitcnt vmcnt(7)
    v_mfma_f32_4x4x4_16b_bf16 v[16:19], v[4:5], v[44:45], v[16:19]
    v_mfma_f32_4x4x4_16b_bf16 v[20:23], v[4:5], v[46:47], v[20:23]
    s_cmp_eq_u32 s40, 20
    s_waitcnt lgkmcnt(0)
    v_mad_u32_u16 v44, v27, s29, v1 op_sel:[1,0,0,0]
    buffer_load_dwordx4 v[44:47], v44, s[12:15], 0 offen
    s_cbranch_scc1 L_d4_0
    v_perm_b32 v4, v28, v28, v3
    v_perm_b32 v5, v28, v28, v6
    ds_read_b32 v28, v9 offset:0
    s_waitcnt vmcnt(7)
    v_mfma_f32_4x4x4_16b_bf16 v[16:19], v[4:5], v[48:49], v[16:19]
    v_mfma_f32_4x4x4_16b_bf16 v[20:23], v[4:5], v[50:51], v[20:23]
    s_cmp_eq_u32 s40, 21
    s_waitcnt lgkmcnt(0)
    v_mad_u32_u16 v48, v28, s29, v1 op_sel:[1,0,0,0]
    buffer_load_dwordx4 v[48:51], v48, s[12:15], 0 offen
L_d5_0:
    v_perm_b32 v4, v29, v29, v3
    v_perm_b32 v5, v29, v29, v6
    s_waitcnt vmcnt(7)
    s_nop 0
    v_mfma_f32_4x4x4_16b_bf16 v[16:19], v[4:5], v[52:53], v[16:19]
    v_mfma_f32_4x4x4_16b_bf16 v[20:23], v[4:5], v[54:55], v[20:23]
L_d5_1:
    v_perm_b32 v4, v30, v30, v3
    v_perm_b32 v5, v30, v30, v6
    s_waitcnt vmcnt(6)
    s_nop 0
    v_mfma_f32_4x4x4_16b_bf16 v[16:19], v[4:5], v[56:57], v[16:19]
    v_mfma_f32_4x4x4_16b_bf16 v[20:23], v[4:5], v[58:59], v[20:23]
L_d5_2:
    v_perm_b32 v4, v31, v31, v3
    v_perm_b32 v5, v31, v31, v6
    s_waitcnt vmcnt(5)
    s_nop 0
    v_mfma_f32_4x4x4_16b_bf16 v[16:19], v[4:5], v[60:61], v[16:19]
    v_mfma_f32_4x4x4_16b_bf16 v[20:23], v[4:5], v[62:63], v[20:23]
L_d5_3:
    v_perm_b32 v4, v24, v24, v3
    v_perm_b32 v5, v24, v24, v6
    s_waitcnt vmcnt(4)
    s_nop 0
    v_mfma_f32_4x4x4_16b_bf16 v[16:19], v[4:5], v[32:33], v[16:19]
    v_mfma_f32_4x4x4_16b_bf16 v[20:23], v[4:5], v[34:35], v[20:23]
L_d5_4:
    v_perm_b32 v4, v25, v25, v3
    v_perm_b32 v5, v25, v25, v6
    s_waitcnt vmcnt(3)
    s_nop 0
    v_mfma_f32_4x4x4_16b_bf16 v[16:19], v[4:5], v[36:37], v[16:19]
    v_mfma_f32_4x4x4_16b_bf16 v[20:23], v[4:5], v[38:39], v[20:23]
L_d5_5:
    v_perm_b32 v4, v26, v26, v3
    v_perm_b32 v5, v26, v26, v6
    s_waitcnt vmcnt(2)
    s_nop 0
    v_mfma_f32_4x4x4_16b_bf16 v[16:19], v[4:5], v[40:41], v[16:19]
    v_mfma_f32_4x4x4_16b_bf16 v[20:23], v[4:5], v[42:43], v[20:23]
L_d5_6:
    v_perm_b32 v4, v27, v27, v3
    v_perm_b32 v5, v27, v27, v6
    s_waitcnt vmcnt(1)
    s_nop 0
    v_mfma_f32_4x4x4_16b_bf16 v[16:19], v[4:5], v[44:45], v[16:19]
    v_mfma_f32_4x4x4_16b_bf16 v[20:23], v[4:5], v[46:47], v[20:23]
L_d5_7:
    v_perm_b32 v4, v28, v28, v3
    v_perm_b32 v5, v28, v28, v6
    s_waitcnt vmcnt(0)
    s_nop 0
    v_mfma_f32_4x4x4_16b_bf16 v[16:19], v[4:5], v[48:49], v[16:19]
    v_mfma_f32_4x4x4_16b_bf16 v[20:23], v[4:5], v[50:51], v[20:23]
    s_branch L_epi
L_d6_0:
    v_perm_b32 v4, v30, v30, v3
    v_perm_b32 v5, v30, v30, v6
    s_waitcnt vmcnt(7)
    s_nop 0
    v_mfma_f32_4x4x4_16b_bf16 v[16:19], v[4:5], v[56:57], v[16:19]
    v_mfma_f32_4x4x4_16b_bf16 v[20:23], v[4:5], v[58:59], v[20:23]
L_d6_1:
    v_perm_b32 v4, v31, v31, v3
    v_perm_b32 v5, v31, v31, v6
    s_waitcnt vmcnt(6)
    s_nop 0
    v_mfma_f32_4x4x4_16b_bf16 v[16:19], v[4:5], v[60:61], v[16:19]
    v_mfma_f32_4x4x4_16b_bf16 v[20:23], v[4:5], v[62:63], v[20:23]
L_d6_2:
    v_perm_b32 v4, v24, v24, v3
    v_perm_b32 v5, v24, v24, v6
    s_waitcnt vmcnt(5)
    s_nop 0
    v_mfma_f32_4x4x4_16b_bf16 v[16:19], v[4:5], v[32:33], v[16:19]
    v_mfma_f32_4x4x4_16b_bf16 v[20:23], v[4:5], v[34:35], v[20:23]
L_d6_3:
    v_perm_b32 v4, v25, v25, v3
    v_perm_b32 v5, v25, v25, v6
    s_waitcnt vmcnt(4)
    s_nop 0
    v_mfma_f32_4x4x4_16b_bf16 v[16:19], v[4:5], v[36:37], v[16:19]
    v_mfma_f32_4x4x4_16b_bf16 v[20:23], v[4:5], v[38:39], v[20:23]
L_d6_4:
    v_perm_b32 v4, v26, v26, v3
    v_perm_b32 v5, v26, v26, v6
    s_waitcnt vmcnt(3)
    s_nop 0
    v_mfma_f32_4x4x4_16b_bf16 v[16:19], v[4:5], v[40:41], v[16:19]
    v_mfma_f32_4x4x4_16b_bf16 v[20:23], v[4:5], v[42:43], v[20:23]
L_d6_5:
    v_perm_b32 v4, v27, v27, v3
    v_perm_b32 v5, v27, v27, v6
    s_waitcnt vmcnt(2)
    s_nop 0
    v_mfma_f32_4x4x4_16b_bf16 v[16:19], v[4:5], v[44:45], v[16:19]
    v_mfma_f32_4x4x4_16b_bf16 v[20:23], v[4:5], v[46:47], v[20:23]
L_d6_6:
    v_perm_b32 v4, v28, v28, v3
    v_perm_b32 v5, v28, v28, v6
    s_waitcnt vmcnt(1)
    s_nop 0
    v_mfma_f32_4x4x4_16b_bf16 v[16:19], v[4:5], v[48:49], v[16:19]
    v_mfma_f32_4x4x4_16b_bf16 v[20:23], v[4:5], v[50:51], v[20:23]
L_d6_7:
    v_perm_b32 v4, v29, v29, v3
    v_perm_b32 v5, v29, v29, v6
    s_waitcnt vmcnt(0)
    s_nop 0
    v_mfma_f32_4x4x4_16b_bf16 v[16:19], v[4:5], v[52:53], v[16:19]
    v_mfma_f32_4x4x4_16b_bf16 v[20:23], v[4:5], v[54:55], v[20:23]
    s_branch L_epi
L_d7_0:
    v_perm_b32 v4, v31, v31, v3
    v_perm_b32 v5, v31, v31, v6
    s_waitcnt vmcnt(7)
    s_nop 0
    v_mfma_f32_4x4x4_16b_bf16 v[16:19], v[4:5], v[60:61], v[16:19]
    v_mfma_f32_4x4x4_16b_bf16 v[20:23], v[4:5], v[62:63], v[20:23]
L_d7_1:
    v_perm_b32 v4, v24, v24, v3
    v_perm_b32 v5, v24, v24, v6
    s_waitcnt vmcnt(6)
    s_nop 0
    v_mfma_f32_4x4x4_16b_bf16 v[16:19], v[4:5], v[32:33], v[16:19]
    v_mfma_f32_4x4x4_16b_bf16 v[20:23], v[4:5], v[34:35], v[20:23]
L_d7_2:
    v_perm_b32 v4, v25, v25, v3
    v_perm_b32 v5, v25, v25, v6
    s_waitcnt vmcnt(5)
    s_nop 0
    v_mfma_f32_4x4x4_16b_bf16 v[16:19], v[4:5], v[36:37], v[16:19]
    v_mfma_f32_4x4x4_16b_bf16 v[20:23], v[4:5], v[38:39], v[20:23]
L_d7_3:
    v_perm_b32 v4, v26, v26, v3
    v_perm_b32 v5, v26, v26, v6
    s_waitcnt vmcnt(4)
    s_nop 0
    v_mfma_f32_4x4x4_16b_bf16 v[16:19], v[4:5], v[40:41], v[16:19]
    v_mfma_f32_4x4x4_16b_bf16 v[20:23], v[4:5], v[42:43], v[20:23]
L_d7_4:
    v_perm_b32 v4, v27, v27, v3
    v_perm_b32 v5, v27, v27, v6
    s_waitcnt vmcnt(3)
    s_nop 0
    v_mfma_f32_4x4x4_16b_bf16 v[16:19], v[4:5], v[44:45], v[16:19]
    v_mfma_f32_4x4x4_16b_bf16 v[20:23], v[4:5], v[46:47], v[20:23]
L_d7_5:
    v_perm_b32 v4, v28, v28, v3
    v_perm_b32 v5, v28, v28, v6
    s_waitcnt vmcnt(2)
    s_nop 0
    v_mfma_f32_4x4x4_16b_bf16 v[16:19], v[4:5], v[48:49], v[16:19]
    v_mfma_f32_4x4x4_16b_bf16 v[20:23], v[4:5], v[50:51], v[20:23]
L_d7_6:
    v_perm_b32 v4, v29, v29, v3
    v_perm_b32 v5, v29, v29, v6
    s_waitcnt vmcnt(1)
    s_nop 0
    v_mfma_f32_4x4x4_16b_bf16 v[16:19], v[4:5], v[52:53], v[16:19]
    v_mfma_f32_4x4x4_16b_bf16 v[20:23], v[4:5], v[54:55], v[20:23]
L_d7_7:
    v_perm_b32 v4, v30, v30, v3
    v_perm_b32 v5, v30, v30, v6
    s_waitcnt vmcnt(0)
    s_nop 0
    v_mfma_f32_4x4x4_16b_bf16 v[16:19], v[4:5], v[56:57], v[16:19]
    v_mfma_f32_4x4x4_16b_bf16 v[20:23], v[4:5], v[58:59], v[20:23]
    s_branch L_epi
L_d0_0:
    v_perm_b32 v4, v24, v24, v3
    v_perm_b32 v5, v24, v24, v6
    s_waitcnt vmcnt(7)
    s_nop 0
    v_mfma_f32_4x4x4_16b_bf16 v[16:19], v[4:5], v[32:33], v[16:19]
    v_mfma_f32_4x4x4_16b_bf16 v[20:23], v[4:5], v[34:35], v[20:23]
L_d0_1:
    v_perm_b32 v4, v25, v25, v3
    v_perm_b32 v5, v25, v25, v6
    s_waitcnt vmcnt(6)
    s_nop 0
    v_mfma_f32_4x4x4_16b_bf16 v[16:19], v[4:5], v[36:37], v[16:19]
    v_mfma_f32_4x4x4_16b_bf16 v[20:23], v[4:5], v[38:39], v[20:23]
L_d0_2:
    v_perm_b32 v4, v26, v26, v3
    v_perm_b32 v5, v26, v26, v6
    s_waitcnt vmcnt(5)
    s_nop 0
    v_mfma_f32_4x4x4_16b_bf16 v[16:19], v[4:5], v[40:41], v[16:19]
    v_mfma_f32_4x4x4_16b_bf16 v[20:23], v[4:5], v[42:43], v[20:23]
L_d0_3:
    v_perm_b32 v4, v27, v27, v3
    v_perm_b32 v5, v27, v27, v6
    s_waitcnt vmcnt(4)
    s_nop 0
    v_mfma_f32_4x4x4_16b_bf16 v[16:19], v[4:5], v[44:45], v[16:19]
    v_mfma_f32_4x4x4_16b_bf16 v[20:23], v[4:5], v[46:47], v[20:23]
L_d0_4:
    v_perm_b32 v4, v28, v28, v3
    v_perm_b32 v5, v28, v28, v6
    s_waitcnt vmcnt(3)
    s_nop 0
    v_mfma_f32_4x4x4_16b_bf16 v[16:19], v[4:5], v[48:49], v[16:19]
    v_mfma_f32_4x4x4_16b_bf16 v[20:23], v[4:5], v[50:51], v[20:23]
L_d0_5:
    v_perm_b32 v4, v29, v29, v3
    v_perm_b32 v5, v29, v29, v6
    s_waitcnt vmcnt(2)
    s_nop 0
    v_mfma_f32_4x4x4_16b_bf16 v[16:19], v[4:5], v[52:53], v[16:19]
    v_mfma_f32_4x4x4_16b_bf16 v[20:23], v[4:5], v[54:55], v[20:23]
L_d0_6:
    v_perm_b32 v4, v30, v30, v3
    v_perm_b32 v5, v30, v30, v6
    s_waitcnt vmcnt(1)
    s_nop 0
    v_mfma_f32_4x4x4_16b_bf16 v[16:19], v[4:5], v[56:57], v[16:19]
    v_mfma_f32_4x4x4_16b_bf16 v[20:23], v[4:5], v[58:59], v[20:23]
L_d0_7:
    v_perm_b32 v4, v31, v31, v3
    v_perm_b32 v5, v31, v31, v6
    s_waitcnt vmcnt(0)
    s_nop 0
    v_mfma_f32_4x4x4_16b_bf16 v[16:19], v[4:5], v[60:61], v[16:19]
    v_mfma_f32_4x4x4_16b_bf16 v[20:23], v[4:5], v[62:63], v[20:23]
    s_branch L_epi
L_d1_0:
    v_perm_b32 v4, v25, v25, v3
    v_perm_b32 v5, v25, v25, v6
    s_waitcnt vmcnt(7)
    s_nop 0
    v_mfma_f32_4x4x4_16b_bf16 v[16:19], v[4:5], v[36:37], v[16:19]
    v_mfma_f32_4x4x4_16b_bf16 v[20:23], v[4:5], v[38:39], v[20:23]
L_d1_1:
    v_perm_b32 v4, v26, v26, v3
    v_perm_b32 v5, v26, v26, v6
    s_waitcnt vmcnt(6)
    s_nop 0
    v_mfma_f32_4x4x4_16b_bf16 v[16:19], v[4:5], v[40:41], v[16:19]
    v_mfma_f32_4x4x4_16b_bf16 v[20:23], v[4:5], v[42:43], v[20:23]
L_d1_2:
    v_perm_b32 v4, v27, v27, v3
    v_perm_b32 v5, v27, v27, v6
    s_waitcnt vmcnt(5)
    s_nop 0
    v_mfma_f32_4x4x4_16b_bf16 v[16:19], v[4:5], v[44:45], v[16:19]
    v_mfma_f32_4x4x4_16b_bf16 v[20:23], v[4:5], v[46:47], v[20:23]
L_d1_3:
    v_perm_b32 v4, v28, v28, v3
    v_perm_b32 v5, v28, v28, v6
    s_waitcnt vmcnt(4)
    s_nop 0
    v_mfma_f32_4x4x4_16b_bf16 v[16:19], v[4:5], v[48:49], v[16:19]
    v_mfma_f32_4x4x4_16b_bf16 v[20:23], v[4:5], v[50:51], v[20:23]
L_d1_4:
    v_perm_b32 v4, v29, v29, v3
    v_perm_b32 v5, v29, v29, v6
    s_waitcnt vmcnt(3)
    s_nop 0
    v_mfma_f32_4x4x4_16b_bf16 v[16:19], v[4:5], v[52:53], v[16:19]
    v_mfma_f32_4x4x4_16b_bf16 v[20:23], v[4:5], v[54:55], v[20:23]
L_d1_5:
    v_perm_b32 v4, v30, v30, v3
    v_perm_b32 v5, v30, v30, v6
    s_waitcnt vmcnt(2)
    s_nop 0
    v_mfma_f32_4x4x4_16b_bf16 v[16:19], v[4:5], v[56:57], v[16:19]
    v_mfma_f32_4x4x4_16b_bf16 v[20:23], v[4:5], v[58:59], v[20:23]
L_d1_6:
    v_perm_b32 v4, v31, v31, v3
    v_perm_b32 v5, v31, v31, v6
    s_waitcnt vmcnt(1)
    s_nop 0
    v_mfma_f32_4x4x4_16b_bf16 v[16:19], v[4:5], v[60:61], v[16:19]
    v_mfma_f32_4x4x4_16b_bf16 v[20:23], v[4:5], v[62:63], v[20:23]
L_d1_7:
    v_perm_b32 v4, v24, v24, v3
    v_perm_b32 v5, v24, v24, v6
    s_waitcnt vmcnt(0)
    s_nop 0
    v_mfma_f32_4x4x4_16b_bf16 v[16:19], v[4:5], v[32:33], v[16:19]
    v_mfma_f32_4x4x4_16b_bf16 v[20:23], v[4:5], v[34:35], v[20:23]
    s_branch L_epi
L_d2_0:
    v_perm_b32 v4, v26, v26, v3
    v_perm_b32 v5, v26, v26, v6
    s_waitcnt vmcnt(7)
    s_nop 0
    v_mfma_f32_4x4x4_16b_bf16 v[16:19], v[4:5], v[40:41], v[16:19]
    v_mfma_f32_4x4x4_16b_bf16 v[20:23], v[4:5], v[42:43], v[20:23]
L_d2_1:
    v_perm_b32 v4, v27, v27, v3
    v_perm_b32 v5, v27, v27, v6
    s_waitcnt vmcnt(6)
    s_nop 0
    v_mfma_f32_4x4x4_16b_bf16 v[16:19], v[4:5], v[44:45], v[16:19]
    v_mfma_f32_4x4x4_16b_bf16 v[20:23], v[4:5], v[46:47], v[20:23]
L_d2_2:
    v_perm_b32 v4, v28, v28, v3
    v_perm_b32 v5, v28, v28, v6
    s_waitcnt vmcnt(5)
    s_nop 0
    v_mfma_f32_4x4x4_16b_bf16 v[16:19], v[4:5], v[48:49], v[16:19]
    v_mfma_f32_4x4x4_16b_bf16 v[20:23], v[4:5], v[50:51], v[20:23]
L_d2_3:
    v_perm_b32 v4, v29, v29, v3
    v_perm_b32 v5, v29, v29, v6
    s_waitcnt vmcnt(4)
    s_nop 0
    v_mfma_f32_4x4x4_16b_bf16 v[16:19], v[4:5], v[52:53], v[16:19]
    v_mfma_f32_4x4x4_16b_bf16 v[20:23], v[4:5], v[54:55], v[20:23]
L_d2_4:
    v_perm_b32 v4, v30, v30, v3
    v_perm_b32 v5, v30, v30, v6
    s_waitcnt vmcnt(3)
    s_nop 0
    v_mfma_f32_4x4x4_16b_bf16 v[16:19], v[4:5], v[56:57], v[16:19]
    v_mfma_f32_4x4x4_16b_bf16 v[20:23], v[4:5], v[58:59], v[20:23]
L_d2_5:
    v_perm_b32 v4, v31, v31, v3
    v_perm_b32 v5, v31, v31, v6
    s_waitcnt vmcnt(2)
    s_nop 0
    v_mfma_f32_4x4x4_16b_bf16 v[16:19], v[4:5], v[60:61], v[16:19]
    v_mfma_f32_4x4x4_16b_bf16 v[20:23], v[4:5], v[62:63], v[20:23]
L_d2_6:
    v_perm_b32 v4, v24, v24, v3
    v_perm_b32 v5, v24, v24, v6
    s_waitcnt vmcnt(1)
    s_nop 0
    v_mfma_f32_4x4x4_16b_bf16 v[16:19], v[4:5], v[32:33], v[16:19]
    v_mfma_f32_4x4x4_16b_bf16 v[20:23], v[4:5], v[34:35], v[20:23]
L_d2_7:
    v_perm_b32 v4, v25, v25, v3
    v_perm_b32 v5, v25, v25, v6
    s_waitcnt vmcnt(0)
    s_nop 0
    v_mfma_f32_4x4x4_16b_bf16 v[16:19], v[4:5], v[36:37], v[16:19]
    v_mfma_f32_4x4x4_16b_bf16 v[20:23], v[4:5], v[38:39], v[20:23]
    s_branch L_epi
L_d3_0:
    v_perm_b32 v4, v27, v27, v3
    v_perm_b32 v5, v27, v27, v6
    s_waitcnt vmcnt(7)
    s_nop 0
    v_mfma_f32_4x4x4_16b_bf16 v[16:19], v[4:5], v[44:45], v[16:19]
    v_mfma_f32_4x4x4_16b_bf16 v[20:23], v[4:5], v[46:47], v[20:23]
L_d3_1:
    v_perm_b32 v4, v28, v28, v3
    v_perm_b32 v5, v28, v28, v6
    s_waitcnt vmcnt(6)
    s_nop 0
    v_mfma_f32_4x4x4_16b_bf16 v[16:19], v[4:5], v[48:49], v[16:19]
    v_mfma_f32_4x4x4_16b_bf16 v[20:23], v[4:5], v[50:51], v[20:23]
L_d3_2:
    v_perm_b32 v4, v29, v29, v3
    v_perm_b32 v5, v29, v29, v6
    s_waitcnt vmcnt(5)
    s_nop 0
    v_mfma_f32_4x4x4_16b_bf16 v[16:19], v[4:5], v[52:53], v[16:19]
    v_mfma_f32_4x4x4_16b_bf16 v[20:23], v[4:5], v[54:55], v[20:23]
L_d3_3:
    v_perm_b32 v4, v30, v30, v3
    v_perm_b32 v5, v30, v30, v6
    s_waitcnt vmcnt(4)
    s_nop 0
    v_mfma_f32_4x4x4_16b_bf16 v[16:19], v[4:5], v[56:57], v[16:19]
    v_mfma_f32_4x4x4_16b_bf16 v[20:23], v[4:5], v[58:59], v[20:23]
L_d3_4:
    v_perm_b32 v4, v31, v31, v3
    v_perm_b32 v5, v31, v31, v6
    s_waitcnt vmcnt(3)
    s_nop 0
    v_mfma_f32_4x4x4_16b_bf16 v[16:19], v[4:5], v[60:61], v[16:19]
    v_mfma_f32_4x4x4_16b_bf16 v[20:23], v[4:5], v[62:63], v[20:23]
L_d3_5:
    v_perm_b32 v4, v24, v24, v3
    v_perm_b32 v5, v24, v24, v6
    s_waitcnt vmcnt(2)
    s_nop 0
    v_mfma_f32_4x4x4_16b_bf16 v[16:19], v[4:5], v[32:33], v[16:19]
    v_mfma_f32_4x4x4_16b_bf16 v[20:23], v[4:5], v[34:35], v[20:23]
L_d3_6:
    v_perm_b32 v4, v25, v25, v3
    v_perm_b32 v5, v25, v25, v6
    s_waitcnt vmcnt(1)
    s_nop 0
    v_mfma_f32_4x4x4_16b_bf16 v[16:19], v[4:5], v[36:37], v[16:19]
    v_mfma_f32_4x4x4_16b_bf16 v[20:23], v[4:5], v[38:39], v[20:23]
L_d3_7:
    v_perm_b32 v4, v26, v26, v3
    v_perm_b32 v5, v26, v26, v6
    s_waitcnt vmcnt(0)
    s_nop 0
    v_mfma_f32_4x4x4_16b_bf16 v[16:19], v[4:5], v[40:41], v[16:19]
    v_mfma_f32_4x4x4_16b_bf16 v[20:23], v[4:5], v[42:43], v[20:23]
    s_branch L_epi
L_d4_0:
    v_perm_b32 v4, v28, v28, v3
    v_perm_b32 v5, v28, v28, v6
    s_waitcnt vmcnt(7)
    s_nop 0
    v_mfma_f32_4x4x4_16b_bf16 v[16:19], v[4:5], v[48:49], v[16:19]
    v_mfma_f32_4x4x4_16b_bf16 v[20:23], v[4:5], v[50:51], v[20:23]
L_d4_1:
    v_perm_b32 v4, v29, v29, v3
    v_perm_b32 v5, v29, v29, v6
    s_waitcnt vmcnt(6)
    s_nop 0
    v_mfma_f32_4x4x4_16b_bf16 v[16:19], v[4:5], v[52:53], v[16:19]
    v_mfma_f32_4x4x4_16b_bf16 v[20:23], v[4:5], v[54:55], v[20:23]
L_d4_2:
    v_perm_b32 v4, v30, v30, v3
    v_perm_b32 v5, v30, v30, v6
    s_waitcnt vmcnt(5)
    s_nop 0
    v_mfma_f32_4x4x4_16b_bf16 v[16:19], v[4:5], v[56:57], v[16:19]
    v_mfma_f32_4x4x4_16b_bf16 v[20:23], v[4:5], v[58:59], v[20:23]
L_d4_3:
    v_perm_b32 v4, v31, v31, v3
    v_perm_b32 v5, v31, v31, v6
    s_waitcnt vmcnt(4)
    s_nop 0
    v_mfma_f32_4x4x4_16b_bf16 v[16:19], v[4:5], v[60:61], v[16:19]
    v_mfma_f32_4x4x4_16b_bf16 v[20:23], v[4:5], v[62:63], v[20:23]
L_d4_4:
    v_perm_b32 v4, v24, v24, v3
    v_perm_b32 v5, v24, v24, v6
    s_waitcnt vmcnt(3)
    s_nop 0
    v_mfma_f32_4x4x4_16b_bf16 v[16:19], v[4:5], v[32:33], v[16:19]
    v_mfma_f32_4x4x4_16b_bf16 v[20:23], v[4:5], v[34:35], v[20:23]
L_d4_5:
    v_perm_b32 v4, v25, v25, v3
    v_perm_b32 v5, v25, v25, v6
    s_waitcnt vmcnt(2)
    s_nop 0
    v_mfma_f32_4x4x4_16b_bf16 v[16:19], v[4:5], v[36:37], v[16:19]
    v_mfma_f32_4x4x4_16b_bf16 v[20:23], v[4:5], v[38:39], v[20:23]
L_d4_6:
    v_perm_b32 v4, v26, v26, v3
    v_perm_b32 v5, v26, v26, v6
    s_waitcnt vmcnt(1)
    s_nop 0
    v_mfma_f32_4x4x4_16b_bf16 v[16:19], v[4:5], v[40:41], v[16:19]
    v_mfma_f32_4x4x4_16b_bf16 v[20:23], v[4:5], v[42:43], v[20:23]
L_d4_7:
    v_perm_b32 v4, v27, v27, v3
    v_perm_b32 v5, v27, v27, v6
    s_waitcnt vmcnt(0)
    s_nop 0
    v_mfma_f32_4x4x4_16b_bf16 v[16:19], v[4:5], v[44:45], v[16:19]
    v_mfma_f32_4x4x4_16b_bf16 v[20:23], v[4:5], v[46:47], v[20:23]
L_epi:
    s_lshl_b32 s46, s47, 10
    s_lshl_b32 s24, s20, 7
    s_add_u32 s24, s24, s46
    v_add_u32 v14, s24, v8
    s_lshl_b32 s24, s47, 2
    s_add_u32 s24, s24, 31760
    v_mov_b32 v11, s24
    v_mov_b32 v12, 1
    s_nop 3
    v_permlane32_swap_b32 v16, v20
    v_permlane32_swap_b32 v17, v21
    v_permlane32_swap_b32 v18, v22
    v_permlane32_swap_b32 v19, v23
    s_nop 1
    v_add_f32 v16, v16, v20
    v_add_f32 v18, v18, v22
    v_add_f32 v17, v17, v21
    v_add_f32 v19, v19, v23
    s_nop 1
    v_permlane16_swap_b32 v16, v18
    v_permlane16_swap_b32 v17, v19
    s_nop 1
    v_add_f32 v16, v16, v18
    v_add_f32 v17, v17, v19
    s_nop 1
    v_add_f32_dpp v20, v16, v16 row_ror:8 row_mask:0xf bank_mask:0xf
    v_add_f32_dpp v21, v17, v17 row_ror:8 row_mask:0xf bank_mask:0xf
    v_cvt_pk_bf16_f32 v22, v20, v21
    s_mov_b64 exec, s[36:37]
    ds_write_b32 v14, v22
    s_mov_b64 exec, 1
    ds_add_rtn_u32 v12, v11, v12
    s_mov_b64 exec, -1
    s_mov_b32 s20, s25
    s_waitcnt lgkmcnt(0)
    v_readfirstlane_b32 s24, v12
    s_and_b32 s24, s24, 7
    s_cmp_lg_u32 s24, 7
    s_cbranch_scc1 L_row
    v_lshlrev_b32 v14, 4, v0
    v_add_u32 v14, s46, v14
    ds_read_b128 v[32:35], v14 offset:0
    v_lshl_add_u32 v15, v2, 7, v1
    s_lshl_b32 s24, s33, 9
    s_add_u32 s24, s24, s22
    s_lshl_b32 s24, s24, 12
    s_waitcnt lgkmcnt(0)
    buffer_store_dwordx4 v[32:35], v15, s[16:19], s24 offen
    s_branch L_row
L_loader:
    s_setprio 3
    s_mov_b32 s47, 1
    s_mov_b32 s26, 0x05040100
    s_mov_b32 s27, 0x07060302
    s_mov_b32 s28, 0x80008000
    s_mov_b32 s40, 0x7fff7fff
    s_mov_b32 s41, 0x00010001
L_ld:
    s_waitcnt vmcnt(0)
    v_mov_b32 v28, v16
    v_mov_b32 v29, v17
    v_mov_b32 v30, v18
    v_mov_b32 v31, v19
    v_mov_b32 v32, v20
    v_mov_b32 v33, v21
    v_mov_b32 v34, v22
    v_mov_b32 v35, v23
    v_mov_b32 v36, v24
    v_mov_b32 v37, v25
    v_mov_b32 v38, v26
    v_mov_b32 v39, v27
    v_or3_b32 v9, v28, v29, v30
    v_or_b32 v9, v9, v31
    v_and_b32 v9, s40, v9
    v_cmp_ne_u32 vcc, 0, v9
    v_mov_b32 v13, 0x80000000
    s_nop 0
    v_cndmask_b32 v10, v13, v15, vcc
    buffer_load_dwordx4 v[40:43], v10, s[8:11], s24 offen offset:0
    buffer_load_dwordx4 v[44:47], v10, s[8:11], s24 offen offset:16
    v_or3_b32 v9, v32, v33, v34
    v_or_b32 v9, v9, v35
    v_and_b32 v9, s40, v9
    v_cmp_ne_u32 vcc, 0, v9
    v_mov_b32 v13, 0x80000000
    s_nop 0
    v_cndmask_b32 v10, v13, v15, vcc
    buffer_load_dwordx4 v[48:51], v10, s[8:11], s24 offen offset:2048
    buffer_load_dwordx4 v[52:55], v10, s[8:11], s24 offen offset:2064
    v_or3_b32 v9, v36, v37, v38
    v_or_b32 v9, v9, v39
    v_and_b32 v9, s40, v9
    v_cmp_ne_u32 vcc, 0, v9
    v_mov_b32 v13, 0x80000000
    s_nop 0
    v_cndmask_b32 v10, v13, v11, vcc
    buffer_load_dwordx4 v[56:59], v10, s[8:11], s24 offen offset:0
    buffer_load_dwordx4 v[60:63], v10, s[8:11], s24 offen offset:16
L_ld2:
    s_add_u32 s23, s23, 1335296
    s_add_u32 s24, s24, 2670592
    s_add_u32 s42, s47, 1
    s_cmp_ge_u32 s42, 4
    s_cbranch_scc1 L_last
    buffer_load_dwordx4 v[16:19], v14, s[4:7], s23 offen
    buffer_load_dwordx4 v[20:23], v14, s[4:7], s23 offen offset:1024
    buffer_load_dwordx4 v[24:27], v12, s[4:7], s23 offen offset:2048
    s_waitcnt vmcnt(3)
    s_branch L_pack
L_last:
    s_waitcnt vmcnt(0)
L_pack:
    s_mul_i32 s46, s47, 6144
    v_add_u32 v13, s46, v15
    v_and_b32 v9, s40, v28
    v_perm_b32 v40, v41, v40, s26
    v_pk_sub_u16 v9, v9, s41
    v_and_or_b32 v40, v9, s28, v40
    v_perm_b32 v41, v40, v28, s27
    v_perm_b32 v40, v40, v28, s26
    v_and_b32 v10, s40, v29
    v_perm_b32 v42, v43, v42, s26
    v_pk_sub_u16 v10, v10, s41
    v_and_or_b32 v42, v10, s28, v42
    v_perm_b32 v43, v42, v29, s27
    v_perm_b32 v42, v42, v29, s26
    v_and_b32 v9, s40, v30
    v_perm_b32 v44, v45, v44, s26
    v_pk_sub_u16 v9, v9, s41
    v_and_or_b32 v44, v9, s28, v44
    v_perm_b32 v45, v44, v30, s27
    v_perm_b32 v44, v44, v30, s26
    v_and_b32 v10, s40, v31
    v_perm_b32 v46, v47, v46, s26
    v_pk_sub_u16 v10, v10, s41
    v_and_or_b32 v46, v10, s28, v46
    v_perm_b32 v47, v46, v31, s27
    v_perm_b32 v46, v46, v31, s26
    ds_write_b128 v13, v[40:43] offset:7168
    ds_write_b128 v13, v[44:47] offset:7184
    v_and_b32 v9, s40, v32
    v_perm_b32 v48, v49, v48, s26
    v_pk_sub_u16 v9, v9, s41
    v_and_or_b32 v48, v9, s28, v48
    v_perm_b32 v49, v48, v32, s27
    v_perm_b32 v48, v48, v32, s26
    v_and_b32 v10, s40, v33
    v_perm_b32 v50, v51, v50, s26
    v_pk_sub_u16 v10, v10, s41
    v_and_or_b32 v50, v10, s28, v50
    v_perm_b32 v51, v50, v33, s27
    v_perm_b32 v50, v50, v33, s26
    v_and_b32 v9, s40, v34
    v_perm_b32 v52, v53, v52, s26
    v_pk_sub_u16 v9, v9, s41
    v_and_or_b32 v52, v9, s28, v52
    v_perm_b32 v53, v52, v34, s27
    v_perm_b32 v52, v52, v34, s26
    v_and_b32 v10, s40, v35
    v_perm_b32 v54, v55, v54, s26
    v_pk_sub_u16 v10, v10, s41
    v_and_or_b32 v54, v10, s28, v54
    v_perm_b32 v55, v54, v35, s27
    v_perm_b32 v54, v54, v35, s26
    ds_write_b128 v13, v[48:51] offset:9216
    ds_write_b128 v13, v[52:55] offset:9232
    v_and_b32 v9, s40, v36
    v_perm_b32 v56, v57, v56, s26
    v_pk_sub_u16 v9, v9, s41
    v_and_or_b32 v56, v9, s28, v56
    v_perm_b32 v57, v56, v36, s27
    v_perm_b32 v56, v56, v36, s26
    v_and_b32 v10, s40, v37
    v_perm_b32 v58, v59, v58, s26
    v_pk_sub_u16 v10, v10, s41
    v_and_or_b32 v58, v10, s28, v58
    v_perm_b32 v59, v58, v37, s27
    v_perm_b32 v58, v58, v37, s26
    v_and_b32 v9, s40, v38
    v_perm_b32 v60, v61, v60, s26
    v_pk_sub_u16 v9, v9, s41
    v_and_or_b32 v60, v9, s28, v60
    v_perm_b32 v61, v60, v38, s27
    v_perm_b32 v60, v60, v38, s26
    v_and_b32 v10, s40, v39
    v_perm_b32 v62, v63, v62, s26
    v_pk_sub_u16 v10, v10, s41
    v_and_or_b32 v62, v10, s28, v62
    v_perm_b32 v63, v62, v39, s27
    v_perm_b32 v62, v62, v39, s26
    ds_write_b128 v13, v[56:59] offset:11264
    ds_write_b128 v13, v[60:63] offset:11280
    v_mov_b32 v9, 31748
    v_mov_b32 v10, s42
    s_mov_b64 exec, 1
    ds_write_b32 v9, v10
    s_mov_b64 exec, -1
    s_mov_b32 s47, s42
    s_cmp_lt_u32 s47, 4
    s_cbranch_scc1 L_ld
    v_mov_b32 v14, 31744
    v_mov_b32 v15, 1
    s_mov_b64 exec, 1
    ds_add_rtn_u32 v14, v14, v15
    s_mov_b64 exec, -1
    s_waitcnt lgkmcnt(0)
    v_readfirstlane_b32 s20, v14
    s_branch L_row
L_fin:
L_end:
    s_endpgm
.section .rodata,"a"
.p2align 6
.amdhsa_kernel standalone__sparse_matmul_formats_ell__sparse_mat_kernel
  .amdhsa_next_free_vgpr 64
  .amdhsa_next_free_sgpr 56
  .amdhsa_accum_offset 64
  .amdhsa_group_segment_fixed_size 0
  .amdhsa_kernarg_size 48
  .amdhsa_user_sgpr_count 2
  .amdhsa_user_sgpr_kernarg_segment_ptr 1
  .amdhsa_system_sgpr_workgroup_id_x 1
.end_amdhsa_kernel
```
